```python
import torch

def _softmax(x, axis=-1):
    return torch.softmax(x, dim=axis)
def _gelu(x):
    return torch.nn.functional.gelu(x, approximate="tanh")
def _silu(x):
    return torch.nn.functional.silu(x)
def _sigmoid(x):
    return torch.sigmoid(x)
def _layernorm(x, axis=-1, eps=1e-5):
    m = x.mean(dim=axis, keepdim=True)
    v = x.var(dim=axis, keepdim=True, unbiased=False)
    return (x - m) / torch.sqrt(v + eps)
def _scatter_add(tgt, idx, src, axis=0):
    return tgt.clone().index_add_(axis, idx, src)
def _segment_sum(src, seg, n):
    out = torch.zeros((n,) + src.shape[1:], dtype=src.dtype)
    return out.index_add_(0, seg, src)
def _pad(x, pw):
    flat = tuple(v for pair in reversed(pw) for v in pair)
    return torch.nn.functional.pad(x, flat)

kernel_name = 'parallel_sum__sliding_block_cached__dense_activation_relu__decode'

def setup_inputs():

    _w = (lambda a: (lambda t: t.to(torch.bfloat16) if t.is_floating_point() else t)(torch.as_tensor(a)))
    def _A_setup():
        B, Sq, D = 8, 1, 512
        Hq, Hkv, Sk, Dh = 32, 8, 8192, 128
        assert Hq % Hkv == 0, (Hq, Hkv)
        return {
            "x": _w((lambda *s: torch.randn(*s, dtype=torch.bfloat16) * 0.05)(B, Sq, D)),
            "k_cache": _w((lambda *s: torch.randn(*s, dtype=torch.bfloat16) * 3.2)(B, Hkv, Sk, Dh)),
            "v_cache": _w((lambda *s: torch.randn(*s, dtype=torch.bfloat16) * 1.6)(B, Hkv, Sk, Dh)),
            "wq": _w((lambda *s: torch.randn(*s, dtype=torch.bfloat16) * 3.2)(D, Hq * Dh) * (D ** -0.5)),
            "wo": _w((lambda *s: torch.randn(*s, dtype=torch.bfloat16) * 1.6)(Hq * Dh, D) * ((Hq * Dh) ** -0.5)),
        }
    _A_in = _A_setup()

    def _B_setup():
        B, S, D, Dff = 8, 1, 512, 1792
        return {
            "x": _w((lambda *s: torch.randn(*s, dtype=torch.bfloat16) * 0.05)(B, S, D)),
            "w1": _w((lambda *s: torch.randn(*s, dtype=torch.bfloat16) * 0.05)(D, Dff)),
            "w2": _w((lambda *s: torch.randn(*s, dtype=torch.bfloat16) * 0.05)(Dff, D)),
        }
    _B_in = _B_setup()

    return {
        "A_x": _A_in["x"],
        "A_k_cache": _A_in["k_cache"],
        "A_v_cache": _A_in["v_cache"],
        "A_wq": _A_in["wq"],
        "A_wo": _A_in["wo"],
        "B_x": _B_in["x"],
        "B_w1": _B_in["w1"],
        "B_w2": _B_in["w2"],
    }

def reference(A_x, A_k_cache, A_v_cache, A_wq, A_wo, B_x, B_w1, B_w2):
    def _A_ref(x, k_cache, v_cache, wq, wo):
        B, Sq, D = x.shape
        Hq, Dh = 32, 128
        Hkv, Sk = k_cache.shape[1], k_cache.shape[2]
        W = min(4096, max(256, Sk // 4))
        rep = Hq // Hkv
        q = (lambda x, *d: x.permute(*d))((x @ wq).reshape(B, Sq, Hq, Dh), 0, 2, 1, 3)
        k = (lambda x, n, axis: torch.repeat_interleave(x, n, dim=axis))(k_cache[:, :, Sk - W:, :], rep, axis=1)
        v = (lambda x, n, axis: torch.repeat_interleave(x, n, dim=axis))(v_cache[:, :, Sk - W:, :], rep, axis=1)
        scores = torch.einsum("bhqd,bhkd->bhqk", q, k) * (Dh ** -0.5)
        p = _softmax(scores, axis=-1)
        o = torch.einsum("bhqk,bhkd->bhqd", p, v)
        return (lambda x, *d: x.permute(*d))(o, 0, 2, 1, 3).reshape(B, Sq, Hq * Dh) @ wo

    def _B_ref(x, w1, w2):
        h = torch.einsum("bsd,df->bsf", x, w1)
        zero = torch.zeros_like(h)
        h = torch.maximum(h, zero)
        return torch.einsum("bsf,fd->bsd", h, w2)

    x = A_x
    xn = _layernorm(x, axis=-1)
    return x + _A_ref(xn, A_k_cache, A_v_cache, A_wq, A_wo) + _B_ref(xn, B_w1, B_w2)
```

```asm
; @launch grid=(256,1,1) block=(1024,1,1) lds=163840
.amdgcn_target "amdgcn-amd-amdhsa--gfx950"
.text
.globl parallel_sum__sliding_block_cached__dense_activation_relu__decode_kernel
.p2align 8
.type parallel_sum__sliding_block_cached__dense_activation_relu__decode_kernel,@function
parallel_sum__sliding_block_cached__dense_activation_relu__decode_kernel:
	s_cmp_ge_u32 s2, 256
	s_cbranch_scc1 L_end
	s_load_dwordx16 s[4:19], s[0:1], 0
	s_load_dwordx4 s[20:23], s[0:1], 64
	s_load_dwordx2 s[24:25], s[0:1], 80
	v_lshrrev_b32 v1, 6, v0
	v_and_b32 v0, 63, v0
	v_readfirstlane_b32 s3, v1
	v_mov_b32 v5, 160384
	v_and_b32 v2, 31, v0
	v_mov_b32 v6, 0
	v_lshl_add_u32 v7, v2, 2, v5
	ds_write_b32 v7, v6
	v_and_b32 v2, 15, v0
	s_and_b32 s28, s2, 7
	s_lshr_b32 s29, s2, 3
	s_lshr_b32 s30, s29, 2
	s_and_b32 s31, s29, 3
	s_lshl_b32 s59, s28, 3
	s_add_u32 s59, s59, s30
	s_cmp_ge_u32 s2, 128
	s_cselect_b32 s56, 2, 1
	s_and_b32 s49, s30, 3
	s_lshl_b32 s49, s49, 3
	s_add_u32 s57, s49, s28
	s_cmp_ge_u32 s57, 28
	s_cselect_b32 s56, 0, s56
	v_lshrrev_b32 v1, 4, v0
	v_bfe_u32 v3, v0, 2, 2
	v_and_b32 v4, 3, v0
	s_lshl_b32 s44, s30, 24
	s_lshl_b32 s45, s28, 21
	s_add_u32 s44, s44, s45
	s_lshl_b32 s45, s31, 17
	s_add_u32 s44, s44, s45
	s_add_u32 s44, s44, 1572864
	s_sub_u32 s50, s3, 2
	s_lshl_b32 s51, s50, 11
	s_and_b32 s45, s50, 1
	s_lshl_b32 s45, s45, 3
	v_xor_b32 v8, v2, v1
	v_xor_b32 v8, s45, v8
	v_lshlrev_b32 v8, 4, v8
	v_lshl_add_u32 v8, v1, 8, v8
	v_xor_b32 v24, 64, v8
	s_mul_i32 s52, s2, 5120
	s_add_u32 s52, s52, s51
	s_waitcnt lgkmcnt(0)
	v_mov_b32 v6, 1
	s_load_dwordx2 s[26:27], s[24:25], 0
	s_mov_b32 s40, s24
	s_mov_b32 s41, s25
	s_mov_b32 s42, 5242880
	s_mov_b32 s43, 0x20000
	s_cmp_lt_u32 s50, 4
	s_cbranch_scc0 L_notload
	s_mov_b32 s32, s6
	s_mov_b32 s33, s7
	s_mov_b32 s34, 0x8000000
	s_mov_b32 s35, 0x20000
	s_setprio 2
	s_mov_b32 s73, 0
L_loopa:
	s_and_b32 s53, s52, 0x1ffff
	s_add_u32 s53, s53, s44
	s_mov_b32 m0, s51
	s_add_u32 s52, s52, 1024
	buffer_load_dwordx4 v8, s[32:35], s53 offen nt lds
	s_add_u32 s51, s51, 1024
	s_and_b32 s53, s52, 0x1ffff
	s_add_u32 s53, s53, s44
	s_mov_b32 m0, s51
	s_add_u32 s52, s52, 7168
	buffer_load_dwordx4 v24, s[32:35], s53 offen nt lds
	s_add_u32 s51, s51, 7168
	s_add_u32 s73, s73, 1
	s_cmp_lt_u32 s73, 3
	s_cbranch_scc1 L_loopa
	s_mov_b32 s74, 0x11114000
	s_lshl_b32 s45, s50, 2
	v_add_u32 v21, s45, v5
	v_mov_b32 v20, 3
	s_mov_b32 s68, s12
	s_mov_b32 s69, s13
	s_mov_b32 s70, 0x400000
	s_mov_b32 s71, 0x20000
	s_and_b32 s49, s50, 1
	s_lshl_b32 s49, s49, 2
	v_add_u32 v9, s49, v1
	v_lshrrev_b32 v14, 1, v2
	v_xor_b32 v14, v14, v9
	v_lshlrev_b32 v14, 5, v14
	v_and_b32 v9, 1, v0
	v_lshl_add_u32 v14, v9, 4, v14
	v_lshl_add_u32 v14, v1, 8, v14
	v_add_u32 v9, 0, v1
	v_lshrrev_b32 v10, 1, v2
	v_xor_b32 v10, v10, v9
	v_lshlrev_b32 v10, 5, v10
	v_and_b32 v9, 1, v0
	v_lshl_add_u32 v10, v9, 4, v10
	v_lshl_add_u32 v10, v1, 10, v10
	v_add_u32 v9, 4, v1
	v_lshrrev_b32 v11, 1, v2
	v_xor_b32 v11, v11, v9
	v_lshlrev_b32 v11, 5, v11
	v_and_b32 v9, 1, v0
	v_lshl_add_u32 v11, v9, 4, v11
	v_lshl_add_u32 v11, v1, 10, v11
	v_lshlrev_b32 v12, 4, v0
	s_lshl_b32 s72, s50, 11
	s_lshl_b32 s61, s59, 13
	s_add_u32 s61, s61, s72
	s_add_u32 s61, s61, 1048576
	v_lshrrev_b32 v13, 1, v1
	v_lshlrev_b32 v13, 11, v13
	v_lshrrev_b32 v9, 3, v2
	v_lshl_add_u32 v13, v9, 10, v13
	v_bfe_u32 v9, v2, 1, 2
	v_lshl_add_u32 v13, v9, 8, v13
	v_and_b32 v9, 1, v1
	v_lshl_add_u32 v13, v9, 7, v13
	v_and_b32 v9, 1, v2
	v_lshl_add_u32 v13, v9, 3, v13
	s_lshl_b32 s46, s50, 5
	s_add_u32 s46, s46, 0
	v_add_u32 v13, s46, v13
	s_lshl_b32 s62, s28, 19
	s_lshl_b32 s54, s50, 17
	s_add_u32 s62, s62, s54
	s_lshl_b32 s54, s30, 14
	s_add_u32 s62, s62, s54
	s_lshl_b32 s54, s31, 8
	s_add_u32 s62, s62, s54
	s_lshl_b32 s63, s50, 12
	s_add_u32 s63, s63, 131072
	s_lshl_b32 s75, s2, 13
	s_add_u32 s75, s75, s72
	s_add_u32 s75, s75, 2097152
	s_add_u32 s76, s75, 1008
	s_add_u32 s77, s75, 2032
	s_lshl_b32 s45, s50, 9
	s_add_u32 s45, s45, 8192
	v_lshl_add_u32 v55, v0, 3, s45
	s_lshl_b32 s45, s2, 5
	v_and_b32 v63, 7, v0
	v_lshl_add_u32 v63, v63, 2, s45
	s_load_dwordx8 s[12:19], s[4:5], s45
	s_barrier
	s_waitcnt lgkmcnt(0)
	s_add_u32 s26, s26, 16
	s_andn2_b32 s26, s26, 15
	s_add_u32 s27, s27, 0x9E3779B9
	v_mov_b32 v60, s26
	v_mov_b32 v61, s27
	v_writelane_b32 v44, s12, 0
	v_writelane_b32 v44, s13, 1
	v_writelane_b32 v44, s14, 2
	v_writelane_b32 v44, s15, 3
	v_writelane_b32 v44, s16, 4
	v_writelane_b32 v44, s17, 5
	v_writelane_b32 v44, s18, 6
	v_writelane_b32 v44, s19, 7
	v_and_b32 v45, 0xffff0000, v44
	v_lshlrev_b32 v44, 16, v44
L_loop:
	s_bitcmp1_b32 s74, s73
	s_cbranch_scc1 L_special
L_loopb:
	s_and_b32 s53, s52, 0x1ffff
	s_add_u32 s53, s53, s44
	s_mov_b32 m0, s51
	s_add_u32 s52, s52, 1024
	buffer_load_dwordx4 v8, s[32:35], s53 offen nt lds
	s_add_u32 s51, s51, 1024
	s_waitcnt vmcnt(6)
	s_and_b32 s53, s52, 0x1ffff
	s_add_u32 s53, s53, s44
	s_mov_b32 m0, s51
	s_add_u32 s52, s52, 7168
	buffer_load_dwordx4 v24, s[32:35], s53 offen nt lds
	s_add_u32 s51, s51, 7168
	s_add_u32 s73, s73, 1
	v_add_u32 v20, 1, v20
	s_waitcnt vmcnt(6)
	ds_write_b32 v21, v20 offset:32
	s_cmp_lt_u32 s73, 32
	s_cbranch_scc1 L_loop
	s_mov_b32 m0, s63
	s_add_u32 s63, s63, 1024
	buffer_load_dwordx4 v10, s[68:71], s62 offen nt lds
	s_add_u32 s62, s62, 4096
	s_waitcnt vmcnt(6)
	s_mov_b32 m0, s63
	s_add_u32 s63, s63, 1024
	buffer_load_dwordx4 v10, s[68:71], s62 offen nt lds
	s_add_u32 s62, s62, 4096
	s_waitcnt vmcnt(6)
	v_add_u32 v20, 1, v20
	ds_write_b32 v21, v20 offset:32
	s_mov_b32 m0, s63
	s_add_u32 s63, s63, 1024
	buffer_load_dwordx4 v11, s[68:71], s62 offen nt lds
	s_add_u32 s62, s62, 4096
	s_waitcnt vmcnt(6)
	s_mov_b32 m0, s63
	s_add_u32 s63, s63, 1024
	buffer_load_dwordx4 v11, s[68:71], s62 offen nt lds
	s_add_u32 s62, s62, 4096
	s_setprio 3
	s_waitcnt vmcnt(4)
	s_barrier
	s_setprio 1
	s_mov_b32 s46, 16384
L_pl_1:
	buffer_load_dwordx4 v[16:19], v12, s[40:43], s61 offen offset:0 sc1
	buffer_load_dwordx4 v[20:23], v12, s[40:43], s61 offen offset:1024 sc1
	s_waitcnt vmcnt(0)
	v_cmp_eq_u64 vcc, s[26:27], v[18:19]
	v_cmp_eq_u64 s[64:65], s[26:27], v[22:23]
	s_nop 0
	s_and_b64 vcc, vcc, s[64:65]
	s_cmp_eq_u64 vcc, exec
	s_cbranch_scc1 L_pld_2
	s_sub_u32 s46, s46, 1
	s_cbranch_scc1 L_pld_2
	s_branch L_pl_1
L_pld_2:
	ds_write_b64 v13, v[16:17] offset:0
	ds_write_b64 v13, v[20:21] offset:16
	s_waitcnt lgkmcnt(0)
	s_barrier
	s_mov_b32 s46, 65536
L_sp_3:
	s_load_dwordx4 s[4:7], s[24:25], s76 glc
	s_load_dwordx4 s[8:11], s[24:25], s77 glc
	s_waitcnt lgkmcnt(0)
	s_xor_b64 s[0:1], s[6:7], s[26:27]
	s_xor_b64 s[10:11], s[10:11], s[26:27]
	s_or_b64 s[0:1], s[0:1], s[10:11]
	s_cmp_eq_u64 s[0:1], 0
	s_cbranch_scc1 L_spd_4
	s_sub_u32 s46, s46, 1
	s_cbranch_scc1 L_spd_4
	s_branch L_sp_3
L_spd_4:
	s_mov_b32 s46, 16384
L_pl_5:
	buffer_load_dwordx4 v[16:19], v12, s[40:43], s75 offen offset:0 sc1
	buffer_load_dwordx4 v[20:23], v12, s[40:43], s75 offen offset:1024 sc1
	s_waitcnt vmcnt(0)
	v_cmp_eq_u64 vcc, s[26:27], v[18:19]
	v_cmp_eq_u64 s[64:65], s[26:27], v[22:23]
	s_nop 0
	s_and_b64 vcc, vcc, s[64:65]
	s_cmp_eq_u64 vcc, exec
	s_cbranch_scc1 L_pld_6
	s_sub_u32 s46, s46, 1
	s_cbranch_scc1 L_pld_6
	s_branch L_pl_5
L_pld_6:
	v_add_f32 v16, v16, v20
	v_add_f32 v17, v17, v21
	ds_write_b64 v55, v[16:17]
	s_waitcnt lgkmcnt(0)
	s_setprio 3
	s_barrier
	s_cmp_lg_u32 s3, 2
	s_cbranch_scc1 L_fin
	ds_read_b64 v[66:67], v55 offset:512
	ds_read_b64 v[68:69], v55 offset:1024
	ds_read_b64 v[70:71], v55 offset:1536
	s_waitcnt lgkmcnt(0)
	v_add_f32 v64, v16, v66
	v_add_f32 v68, v68, v70
	v_add_f32 v65, v17, v67
	v_add_f32 v69, v69, v71
	v_add_f32 v64, v64, v68
	v_add_f32 v65, v65, v69
	s_nop 0
	v_add_f32_dpp v64, v64, v64 row_ror:8 row_mask:0xf bank_mask:0xf
	v_add_f32_dpp v65, v65, v65 row_ror:8 row_mask:0xf bank_mask:0xf
	v_mov_b32 v66, v64
	v_mov_b32 v67, v65
	s_nop 0
	v_permlane16_swap_b32 v64, v66
	v_permlane16_swap_b32 v65, v67
	v_add_f32 v64, v64, v66
	v_add_f32 v65, v65, v67
	v_mov_b32 v66, v64
	v_mov_b32 v67, v65
	s_nop 0
	v_permlane32_swap_b32 v64, v66
	v_permlane32_swap_b32 v65, v67
	v_add_f32 v64, v64, v66
	v_add_f32 v65, v65, v67
	v_add_f32 v64, v44, v64
	v_add_f32 v65, v45, v65
	v_cvt_pk_bf16_f32 v64, v64, v65
	s_mov_b64 exec, 0xff
	global_store_dword v63, v64, s[20:21] sc0 sc1
	s_cmp_lg_u32 s2, 0
	s_cbranch_scc1 L_fin
	s_mov_b64 exec, 1
	v_mov_b32 v8, 0
	global_store_dwordx2 v8, v[60:61], s[24:25] sc1
	s_branch L_fin
L_special:
	s_cmp_lg_u32 s73, 14
	s_cbranch_scc1 L_sp3
	s_mov_b32 s46, 262144
L_fw_7:
	ds_read_b32 v7, v5 offset:4
	s_waitcnt lgkmcnt(0)
	v_readfirstlane_b32 s47, v7
	s_nop 0
	s_cmp_ge_u32 s47, 2
	s_cbranch_scc1 L_fwd_8
	s_sub_u32 s46, s46, 1
	s_cbranch_scc1 L_fwd_8
	s_sleep 1
	s_branch L_fw_7
L_fwd_8:
	s_branch L_loopb
L_sp3:
	s_cmp_lg_u32 s73, 16
	s_cbranch_scc1 L_sp4
	s_mov_b32 s32, s8
	s_mov_b32 s33, s9
	v_mov_b32 v8, v14
	v_mov_b32 v24, v14
	s_lshl_b32 s51, s50, 11
L_sp4:
	s_sub_u32 s45, s73, 16
	v_add_u32 v22, s45, v5
	s_mov_b32 s46, 262144
L_sp5:
	ds_read_b32 v7, v22 offset:48
	s_waitcnt lgkmcnt(0)
	v_readfirstlane_b32 s47, v7
	s_nop 0
	s_cmp_ge_u32 s47, 8
	s_cbranch_scc1 L_loopb
	s_sub_u32 s46, s46, 1
	s_cbranch_scc1 L_loopb
	s_sleep 1
	s_branch L_sp5
L_notload:
	s_cmp_lt_u32 s3, 8
	s_cbranch_scc1 L_ctrl
	s_setprio 3
	s_sub_u32 s50, s3, 8
	s_lshl_b32 s45, s50, 10
	v_lshl_add_u32 v7, v0, 4, s45
	global_load_dwordx4 v[8:11], v7, s[4:5]
	s_mov_b32 s32, s10
	s_mov_b32 s33, s11
	s_mov_b32 s34, 0x400000
	s_mov_b32 s35, 0x20000
	v_lshrrev_b32 v12, 3, v0
	v_and_b32 v13, 7, v0
	v_lshlrev_b32 v13, 4, v13
	v_lshl_add_u32 v14, v12, 13, v13
	s_lshl_b32 s60, s31, 3
	s_add_u32 s60, s60, s50
	s_lshl_b32 s60, s60, 4
	s_lshl_b32 s45, s60, 13
	s_add_u32 s72, s28, 0
	s_and_b32 s72, s72, 7
	s_lshl_b32 s46, s72, 10
	s_add_u32 s45, s45, s46
	s_lshl_b32 s46, s30, 7
	s_add_u32 s45, s45, s46
	s_lshl_b32 s47, s50, 11
	s_add_u32 s48, s47, 131072
	s_mov_b32 m0, s48
	s_nop 0
	buffer_load_dwordx4 v14, s[32:35], s45 offen nt lds
	s_add_u32 s45, s45, 0x10000
	s_add_u32 s48, s48, 1024
	s_mov_b32 m0, s48
	s_nop 0
	buffer_load_dwordx4 v14, s[32:35], s45 offen nt lds
	s_cmp_eq_u32 s56, 0
	s_cbranch_scc1 L_roledone
	s_cmp_eq_u32 s56, 2
	s_cbranch_scc1 L_role2
	s_mov_b32 s36, s16
	s_mov_b32 s37, s17
	s_mov_b32 s38, 1835008
	s_mov_b32 s39, 0x20000
	s_movk_i32 s49, 3584
	v_mul_lo_u32 v15, v12, s49
	v_add_u32 v15, v15, v13
	s_mul_i32 s45, s60, 3584
	s_lshl_b32 s46, s57, 7
	s_add_u32 s45, s45, s46
	s_add_u32 s48, s47, 114688
	s_mov_b32 m0, s48
	s_nop 0
	buffer_load_dwordx4 v15, s[36:39], s45 offen nt lds
	s_add_u32 s45, s45, 28672
	s_add_u32 s48, s48, 1024
	s_mov_b32 m0, s48
	s_nop 0
	buffer_load_dwordx4 v15, s[36:39], s45 offen nt lds
	s_branch L_roledone
L_role2:
	s_mov_b32 s36, s18
	s_mov_b32 s37, s19
	s_mov_b32 s38, 1835008
	s_mov_b32 s39, 0x20000
	s_and_b32 s49, s50, 1
	s_lshl_b32 s49, s49, 2
	v_add_u32 v16, s49, v1
	v_lshrrev_b32 v15, 1, v2
	v_xor_b32 v15, v15, v16
	v_lshlrev_b32 v15, 5, v15
	v_and_b32 v16, 1, v0
	v_lshl_add_u32 v15, v16, 4, v15
	v_lshl_add_u32 v15, v1, 10, v15
	s_lshl_b32 s45, s57, 16
	s_lshl_b32 s46, s50, 13
	s_add_u32 s45, s45, s46
	s_lshl_b32 s46, s31, 8
	s_add_u32 s45, s45, s46
	s_add_u32 s48, s47, 114688
	s_mov_b32 m0, s48
	s_nop 0
	buffer_load_dwordx4 v15, s[36:39], s45 offen nt lds
	s_add_u32 s45, s45, 4096
	s_add_u32 s48, s48, 1024
	s_mov_b32 m0, s48
	s_nop 0
	buffer_load_dwordx4 v15, s[36:39], s45 offen nt lds
L_roledone:
	s_barrier
	s_waitcnt lgkmcnt(0)
	s_add_u32 s26, s26, 16
	s_andn2_b32 s26, s26, 15
	s_add_u32 s27, s27, 0x9E3779B9
	v_mov_b32 v58, s26
	v_mov_b32 v59, s27
	s_waitcnt vmcnt(2)
	v_lshlrev_b32 v12, 16, v8
	v_and_b32 v13, 0xffff0000, v8
	v_lshlrev_b32 v14, 16, v9
	v_and_b32 v15, 0xffff0000, v9
	v_lshlrev_b32 v16, 16, v10
	v_and_b32 v17, 0xffff0000, v10
	v_lshlrev_b32 v18, 16, v11
	v_and_b32 v19, 0xffff0000, v11
	v_add_f32 v20, v12, v13
	v_add_f32 v21, v14, v15
	v_add_f32 v22, v16, v17
	v_add_f32 v23, v18, v19
	v_add_f32 v20, v20, v21
	v_add_f32 v22, v22, v23
	v_add_f32 v20, v20, v22
	s_nop 1
	v_add_f32_dpp v20, v20, v20 row_ror:8 row_mask:0xf bank_mask:0xf
	s_nop 1
	v_add_f32_dpp v20, v20, v20 row_ror:4 row_mask:0xf bank_mask:0xf
	s_nop 1
	v_add_f32_dpp v20, v20, v20 row_ror:2 row_mask:0xf bank_mask:0xf
	s_nop 1
	v_add_f32_dpp v20, v20, v20 row_ror:1 row_mask:0xf bank_mask:0xf
	v_mov_b32 v21, v20
	s_nop 1
	v_permlane16_swap_b32 v20, v21
	v_add_f32 v20, v20, v21
	v_mov_b32 v21, v20
	s_nop 1
	v_permlane32_swap_b32 v20, v21
	v_add_f32 v20, v20, v21
	v_mul_f32 v20, 0x3b000000, v20
	v_sub_f32 v24, v12, v20
	v_sub_f32 v25, v13, v20
	v_sub_f32 v26, v14, v20
	v_sub_f32 v27, v15, v20
	v_sub_f32 v28, v16, v20
	v_sub_f32 v29, v17, v20
	v_sub_f32 v30, v18, v20
	v_sub_f32 v31, v19, v20
	v_mul_f32 v21, v24, v24
	v_fmac_f32 v21, v25, v25
	v_fmac_f32 v21, v26, v26
	v_fmac_f32 v21, v27, v27
	v_fmac_f32 v21, v28, v28
	v_fmac_f32 v21, v29, v29
	v_fmac_f32 v21, v30, v30
	v_fmac_f32 v21, v31, v31
	s_nop 1
	v_add_f32_dpp v21, v21, v21 row_ror:8 row_mask:0xf bank_mask:0xf
	s_nop 1
	v_add_f32_dpp v21, v21, v21 row_ror:4 row_mask:0xf bank_mask:0xf
	s_nop 1
	v_add_f32_dpp v21, v21, v21 row_ror:2 row_mask:0xf bank_mask:0xf
	s_nop 1
	v_add_f32_dpp v21, v21, v21 row_ror:1 row_mask:0xf bank_mask:0xf
	v_mov_b32 v22, v21
	s_nop 1
	v_permlane16_swap_b32 v21, v22
	v_add_f32 v21, v21, v22
	v_mov_b32 v22, v21
	s_nop 1
	v_permlane32_swap_b32 v21, v22
	v_add_f32 v21, v21, v22
	v_mul_f32 v21, 0x3b000000, v21
	v_cvt_pk_bf16_f32 v22, v20, v21
	v_lshlrev_b32 v20, 16, v22
	v_and_b32 v21, 0xffff0000, v22
	v_add_f32 v21, 925353388, v21
	v_cvt_pk_bf16_f32 v21, v21, v21
	v_and_b32 v21, 0xffff0000, v21
	v_sqrt_f32 v21, v21
	s_nop 0
	v_cvt_pk_bf16_f32 v21, v21, v21
	v_and_b32 v21, 0xffff0000, v21
	v_rcp_f32 v22, v21
	v_sub_f32 v12, v12, v20
	v_sub_f32 v13, v13, v20
	v_sub_f32 v14, v14, v20
	v_sub_f32 v15, v15, v20
	v_sub_f32 v16, v16, v20
	v_sub_f32 v17, v17, v20
	v_sub_f32 v18, v18, v20
	v_sub_f32 v19, v19, v20
	v_cvt_pk_bf16_f32 v8, v12, v13
	v_cvt_pk_bf16_f32 v9, v14, v15
	v_cvt_pk_bf16_f32 v10, v16, v17
	v_cvt_pk_bf16_f32 v11, v18, v19
	v_lshlrev_b32 v12, 16, v8
	v_and_b32 v13, 0xffff0000, v8
	v_lshlrev_b32 v14, 16, v9
	v_and_b32 v15, 0xffff0000, v9
	v_lshlrev_b32 v16, 16, v10
	v_and_b32 v17, 0xffff0000, v10
	v_lshlrev_b32 v18, 16, v11
	v_and_b32 v19, 0xffff0000, v11
	v_mul_f32 v24, v12, v22
	v_mul_f32 v25, v13, v22
	v_mul_f32 v26, v14, v22
	v_mul_f32 v27, v15, v22
	v_mul_f32 v28, v16, v22
	v_mul_f32 v29, v17, v22
	v_mul_f32 v30, v18, v22
	v_mul_f32 v31, v19, v22
	v_fma_f32 v12, -v24, v21, v12
	v_fma_f32 v13, -v25, v21, v13
	v_fma_f32 v14, -v26, v21, v14
	v_fma_f32 v15, -v27, v21, v15
	v_fma_f32 v16, -v28, v21, v16
	v_fma_f32 v17, -v29, v21, v17
	v_fma_f32 v18, -v30, v21, v18
	v_fma_f32 v19, -v31, v21, v19
	v_fmac_f32 v24, v12, v22
	v_fmac_f32 v25, v13, v22
	v_fmac_f32 v26, v14, v22
	v_fmac_f32 v27, v15, v22
	v_fmac_f32 v28, v16, v22
	v_fmac_f32 v29, v17, v22
	v_fmac_f32 v30, v18, v22
	v_fmac_f32 v31, v19, v22
	v_cvt_pk_bf16_f32 v8, v24, v25
	v_cvt_pk_bf16_f32 v9, v26, v27
	v_cvt_pk_bf16_f32 v10, v28, v29
	v_cvt_pk_bf16_f32 v11, v30, v31
	s_mul_i32 s45, s50, 1040
	s_add_u32 s45, s45, 147456
	v_lshl_add_u32 v7, v0, 4, s45
	ds_write_b128 v7, v[8:11]
	s_waitcnt vmcnt(0)
	s_mov_b64 exec, 1
	ds_add_u32 v5, v6 offset:0
	s_mov_b64 exec, -1
	s_setprio 0
	s_lshl_b32 s45, s50, 12
	v_xor_b32 v8, v1, v2
	v_lshlrev_b32 v8, 4, v8
	v_lshl_add_u32 v8, v2, 8, v8
	v_add_u32 v8, s45, v8
	v_xor_b32 v54, 64, v8
	v_xor_b32 v55, 128, v8
	v_xor_b32 v60, 192, v8
	v_lshlrev_b32 v9, 8, v4
	v_lshl_add_u32 v9, v1, 4, v9
	v_add_u32 v9, 160512, v9
	s_lshl_b32 s45, s50, 2
	s_add_u32 s45, s45, 160128
	v_lshlrev_b32 v10, 5, v4
	v_add_u32 v11, s45, v10
	v_add_u32 v10, 160128, v10
	s_movk_i32 s45, 1088
	v_mul_lo_u32 v12, v4, s45
	v_lshl_add_u32 v13, v3, 8, v12
	v_lshl_add_u32 v13, v1, 3, v13
	s_lshl_b32 s45, s50, 5
	s_add_u32 s45, s45, 155776
	v_add_u32 v13, s45, v13
	v_lshl_add_u32 v14, v1, 4, v12
	v_add_u32 v14, 155776, v14
	v_and_b32 v15, 1, v1
	v_lshl_add_u32 v15, v15, 2, v3
	v_xor_b32 v15, s50, v15
	v_lshlrev_b32 v15, 5, v15
	v_lshl_add_u32 v16, v1, 3, v3
	v_lshl_add_u32 v15, v16, 8, v15
	v_lshl_add_u32 v15, v4, 3, v15
	v_add_u32 v16, 0x10000, v15
	v_add_u32 v17, 131072, v15
	v_lshlrev_b32 v48, 6, v4
	v_lshl_add_u32 v48, v1, 4, v48
	s_lshl_b32 s54, s28, 3
	s_add_u32 s54, s54, s50
	s_lshl_b32 s54, s54, 13
	s_lshl_b32 s45, s29, 8
	s_add_u32 s54, s54, s45
	s_add_u32 s54, s54, 1048576
	v_and_b32 v49, 7, v2
	v_lshlrev_b32 v49, 18, v49
	v_lshl_add_u32 v49, v1, 5, v49
	v_lshrrev_b32 v22, 3, v2
	v_lshl_add_u32 v49, v22, 4, v49
	s_lshl_b32 s58, s31, 3
	s_add_u32 s58, s58, s50
	s_lshl_b32 s58, s58, 13
	s_lshl_b32 s45, s59, 7
	s_add_u32 s58, s58, s45
	s_add_u32 s58, s58, 2097152
	v_lshlrev_b32 v23, 4, v0
	v_add_u32 v23, 0, v23
	v_lshlrev_b32 v50, 2, v4
	v_add_u32 v50, 161536, v50
	s_lshl_b32 s45, s50, 9
	s_add_u32 s45, s45, 147456
	v_lshl_add_u32 v51, v0, 3, s45
	s_mov_b32 s48, 0xff00ff00
	s_mov_b32 s49, 0xff00ff00
	s_mov_b32 s46, 262144
L_w4_9:
	ds_read_b128 v[44:47], v5 offset:32
	s_waitcnt lgkmcnt(0)
	v_min3_u32 v44, v44, v45, v46
	v_min_u32 v44, v44, v47
	s_nop 0
	v_readfirstlane_b32 s47, v44
	s_nop 0
	s_cmp_ge_u32 s47, 7
	s_cbranch_scc1 L_w4d_10
	s_sub_u32 s46, s46, 1
	s_cbranch_scc1 L_w4d_10
	s_sleep 4
	s_branch L_w4_9
L_w4d_10:
	ds_read_b128 v[64:67], v8 offset:0
	ds_read_b128 v[68:71], v54 offset:0
	ds_read_b128 v[72:75], v55 offset:0
	ds_read_b128 v[76:79], v60 offset:0
	s_waitcnt lgkmcnt(0)
	s_mov_b64 exec, 1
	ds_add_u32 v5, v6 offset:48
	s_mov_b64 exec, -1
	s_mov_b32 s46, 262144
L_w4_11:
	ds_read_b128 v[44:47], v5 offset:32
	s_waitcnt lgkmcnt(0)
	v_min3_u32 v44, v44, v45, v46
	v_min_u32 v44, v44, v47
	s_nop 0
	v_readfirstlane_b32 s47, v44
	s_nop 0
	s_cmp_ge_u32 s47, 11
	s_cbranch_scc1 L_w4d_12
	s_sub_u32 s46, s46, 1
	s_cbranch_scc1 L_w4d_12
	s_sleep 4
	s_branch L_w4_11
L_w4d_12:
	ds_read_b128 v[80:83], v8 offset:32768
	ds_read_b128 v[84:87], v54 offset:32768
	ds_read_b128 v[88:91], v55 offset:32768
	ds_read_b128 v[92:95], v60 offset:32768
	v_add_u32 v8, 0x10000, v8
	v_add_u32 v54, 0x10000, v54
	v_add_u32 v55, 0x10000, v55
	v_add_u32 v60, 0x10000, v60
	s_waitcnt lgkmcnt(0)
	s_mov_b64 exec, 1
	ds_add_u32 v5, v6 offset:52
	s_mov_b64 exec, -1
	s_mov_b32 s46, 262144
L_w4_13:
	ds_read_b128 v[44:47], v5 offset:32
	s_waitcnt lgkmcnt(0)
	v_min3_u32 v44, v44, v45, v46
	v_min_u32 v44, v44, v47
	s_nop 0
	v_readfirstlane_b32 s47, v44
	s_nop 0
	s_cmp_ge_u32 s47, 15
	s_cbranch_scc1 L_w4d_14
	s_sub_u32 s46, s46, 1
	s_cbranch_scc1 L_w4d_14
	s_sleep 4
	s_branch L_w4_13
L_w4d_14:
	ds_read_b128 v[96:99], v8 offset:0
	ds_read_b128 v[100:103], v54 offset:0
	ds_read_b128 v[104:107], v55 offset:0
	ds_read_b128 v[108:111], v60 offset:0
	s_waitcnt lgkmcnt(0)
	s_mov_b64 exec, 1
	ds_add_u32 v5, v6 offset:56
	s_mov_b64 exec, -1
	s_mov_b32 s46, 262144
L_w4_15:
	ds_read_b128 v[44:47], v5 offset:32
	s_waitcnt lgkmcnt(0)
	v_min3_u32 v44, v44, v45, v46
	v_min_u32 v44, v44, v47
	s_nop 0
	v_readfirstlane_b32 s47, v44
	s_nop 0
	s_cmp_ge_u32 s47, 19
	s_cbranch_scc1 L_w4d_16
	s_sub_u32 s46, s46, 1
	s_cbranch_scc1 L_w4d_16
	s_sleep 1
	s_branch L_w4_15
L_w4d_16:
	ds_read_b128 v[112:115], v8 offset:32768
	ds_read_b128 v[116:119], v54 offset:32768
	ds_read_b128 v[120:123], v55 offset:32768
	ds_read_b128 v[124:127], v60 offset:32768
	s_waitcnt lgkmcnt(0)
	s_mov_b64 exec, 1
	ds_add_u32 v5, v6 offset:60
	s_mov_b64 exec, -1
	s_mov_b32 s46, 262144
L_fw_17:
	ds_read_b32 v7, v5 offset:24
	s_waitcnt lgkmcnt(0)
	v_readfirstlane_b32 s47, v7
	s_nop 0
	s_cmp_ge_u32 s47, 1
	s_cbranch_scc1 L_fwd_18
	s_sub_u32 s46, s46, 1
	s_cbranch_scc1 L_fwd_18
	s_sleep 1
	s_branch L_fw_17
L_fwd_18:
	s_mov_b32 s79, s47
	s_mov_b32 s46, 262144
L_fw_19:
	ds_read_b32 v7, v5 offset:16
	s_waitcnt lgkmcnt(0)
	v_readfirstlane_b32 s47, v7
	s_nop 0
	s_cmp_ge_u32 s47, 1
	s_cbranch_scc1 L_fwd_20
	s_sub_u32 s46, s46, 1
	s_cbranch_scc1 L_fwd_20
	s_sleep 1
	s_branch L_fw_19
L_fwd_20:
	s_setprio 3
	ds_read_b128 v[18:21], v9 offset:0
	ds_read_b128 v[28:31], v9 offset:64
	ds_read_b128 v[44:47], v9 offset:128
	ds_read_b128 v[52:55], v9 offset:192
	s_waitcnt lgkmcnt(3)
	v_mfma_f32_16x16x32_bf16 v[24:27], v[64:67], v[18:21], 0
	v_mfma_f32_16x16x32_bf16 v[32:35], v[80:83], v[18:21], 0
	v_mfma_f32_16x16x32_bf16 v[36:39], v[96:99], v[18:21], 0
	v_mfma_f32_16x16x32_bf16 v[40:43], v[112:115], v[18:21], 0
	s_waitcnt lgkmcnt(2)
	v_mfma_f32_16x16x32_bf16 v[24:27], v[68:71], v[28:31], v[24:27]
	v_mfma_f32_16x16x32_bf16 v[32:35], v[84:87], v[28:31], v[32:35]
	v_mfma_f32_16x16x32_bf16 v[36:39], v[100:103], v[28:31], v[36:39]
	v_mfma_f32_16x16x32_bf16 v[40:43], v[116:119], v[28:31], v[40:43]
	s_waitcnt lgkmcnt(1)
	v_mfma_f32_16x16x32_bf16 v[24:27], v[72:75], v[44:47], v[24:27]
	v_mfma_f32_16x16x32_bf16 v[32:35], v[88:91], v[44:47], v[32:35]
	v_mfma_f32_16x16x32_bf16 v[36:39], v[104:107], v[44:47], v[36:39]
	v_mfma_f32_16x16x32_bf16 v[40:43], v[120:123], v[44:47], v[40:43]
	s_waitcnt lgkmcnt(0)
	v_mfma_f32_16x16x32_bf16 v[24:27], v[76:79], v[52:55], v[24:27]
	v_mfma_f32_16x16x32_bf16 v[32:35], v[92:95], v[52:55], v[32:35]
	v_mfma_f32_16x16x32_bf16 v[36:39], v[108:111], v[52:55], v[36:39]
	v_mfma_f32_16x16x32_bf16 v[40:43], v[124:127], v[52:55], v[40:43]
	s_nop 5
	v_mov_b32_dpp v24, v32 quad_perm:[0,1,2,3] row_mask:0xf bank_mask:0x2
	v_mov_b32_dpp v25, v33 quad_perm:[0,1,2,3] row_mask:0xf bank_mask:0x2
	v_mov_b32_dpp v26, v34 quad_perm:[0,1,2,3] row_mask:0xf bank_mask:0x2
	v_mov_b32_dpp v27, v35 quad_perm:[0,1,2,3] row_mask:0xf bank_mask:0x2
	v_mov_b32_dpp v24, v36 quad_perm:[0,1,2,3] row_mask:0xf bank_mask:0x4
	v_mov_b32_dpp v25, v37 quad_perm:[0,1,2,3] row_mask:0xf bank_mask:0x4
	v_mov_b32_dpp v26, v38 quad_perm:[0,1,2,3] row_mask:0xf bank_mask:0x4
	v_mov_b32_dpp v27, v39 quad_perm:[0,1,2,3] row_mask:0xf bank_mask:0x4
	v_mov_b32_dpp v24, v40 quad_perm:[0,1,2,3] row_mask:0xf bank_mask:0x8
	v_mov_b32_dpp v25, v41 quad_perm:[0,1,2,3] row_mask:0xf bank_mask:0x8
	v_mov_b32_dpp v26, v42 quad_perm:[0,1,2,3] row_mask:0xf bank_mask:0x8
	v_mov_b32_dpp v27, v43 quad_perm:[0,1,2,3] row_mask:0xf bank_mask:0x8
	v_cvt_pk_bf16_f32 v28, v24, v25
	v_cvt_pk_bf16_f32 v29, v26, v27
	v_lshlrev_b32 v24, 16, v28
	v_and_b32 v25, 0xffff0000, v28
	v_lshlrev_b32 v26, 16, v29
	v_and_b32 v27, 0xffff0000, v29
	v_mul_f32 v24, 0x3db504f3, v24
	v_mul_f32 v25, 0x3db504f3, v25
	v_mul_f32 v26, 0x3db504f3, v26
	v_mul_f32 v27, 0x3db504f3, v27
	v_cvt_pk_bf16_f32 v28, v24, v25
	v_cvt_pk_bf16_f32 v29, v26, v27
	v_lshlrev_b32 v24, 16, v28
	v_and_b32 v25, 0xffff0000, v28
	v_lshlrev_b32 v26, 16, v29
	v_and_b32 v27, 0xffff0000, v29
	v_max3_f32 v28, v24, v25, v26
	v_max_f32 v28, v28, v27
	s_nop 1
	v_max_f32_dpp v28, v28, v28 row_ror:4 row_mask:0xf bank_mask:0xf
	s_nop 1
	v_max_f32_dpp v28, v28, v28 row_ror:8 row_mask:0xf bank_mask:0xf
	v_mov_b32 v29, v28
	s_nop 1
	v_permlane16_swap_b32 v28, v29
	v_max_f32 v28, v28, v29
	v_mov_b32 v29, v28
	s_nop 1
	v_permlane32_swap_b32 v28, v29
	v_max_f32 v28, v28, v29
	s_mov_b64 exec, 0xf
	ds_write_b32 v11, v28
	s_mov_b64 exec, -1
	s_mov_b64 exec, 1
	ds_add_u32 v5, v6 offset:8
	s_mov_b64 exec, -1
	s_mov_b32 s46, 262144
L_fw_21:
	ds_read_b32 v7, v5 offset:8
	s_waitcnt lgkmcnt(0)
	v_readfirstlane_b32 s47, v7
	s_nop 0
	s_cmp_ge_u32 s47, 8
	s_cbranch_scc1 L_fwd_22
	s_sub_u32 s46, s46, 1
	s_cbranch_scc1 L_fwd_22
	s_branch L_fw_21
L_fwd_22:
	ds_read_b128 v[32:35], v10
	ds_read_b128 v[36:39], v10 offset:16
	s_waitcnt lgkmcnt(0)
	v_max3_f32 v32, v32, v33, v34
	v_max3_f32 v36, v36, v37, v38
	v_max3_f32 v32, v32, v35, v39
	v_max_f32 v56, v32, v36
	s_mov_b32 s45, 0x3fb8aa3b
	v_sub_f32 v24, v24, v56
	v_sub_f32 v25, v25, v56
	v_sub_f32 v26, v26, v56
	v_sub_f32 v27, v27, v56
	v_mul_f32 v24, s45, v24
	v_mul_f32 v25, s45, v25
	v_mul_f32 v26, s45, v26
	v_mul_f32 v27, s45, v27
	v_exp_f32 v24, v24
	v_exp_f32 v25, v25
	v_exp_f32 v26, v26
	v_exp_f32 v27, v27
	v_add_f32 v28, v24, v25
	v_add_f32 v29, v26, v27
	v_add_f32 v28, v28, v29
	v_cvt_pk_bf16_f32 v30, v24, v25
	v_cvt_pk_bf16_f32 v31, v26, v27
	ds_write_b64 v13, v[30:31]
	v_add_f32_dpp v28, v28, v28 row_ror:4 row_mask:0xf bank_mask:0xf
	s_nop 1
	v_add_f32_dpp v28, v28, v28 row_ror:8 row_mask:0xf bank_mask:0xf
	v_mov_b32 v29, v28
	s_nop 1
	v_permlane16_swap_b32 v28, v29
	v_add_f32 v28, v28, v29
	v_mov_b32 v29, v28
	s_nop 1
	v_permlane32_swap_b32 v28, v29
	v_add_f32 v28, v28, v29
	s_mov_b64 exec, 0xf
	ds_write_b32 v11, v28 offset:128
	s_mov_b64 exec, -1
	s_mov_b64 exec, 1
	ds_add_u32 v5, v6 offset:20
	s_mov_b64 exec, -1
	s_mov_b32 s46, 262144
L_fw_23:
	ds_read_b32 v7, v5 offset:20
	s_waitcnt lgkmcnt(0)
	v_readfirstlane_b32 s47, v7
	s_nop 0
	s_cmp_ge_u32 s47, 8
	s_cbranch_scc1 L_fwd_24
	s_sub_u32 s46, s46, 1
	s_cbranch_scc1 L_fwd_24
	s_branch L_fw_23
L_fwd_24:
	s_cmp_lg_u32 s50, 0
	s_cbranch_scc1 L_noml
	s_setprio 3
	ds_read_b128 v[32:35], v10 offset:128
	ds_read_b128 v[36:39], v10 offset:144
	v_lshlrev_b32 v24, 11, v3
	v_lshl_add_u32 v24, v4, 4, v24
	s_lshl_b32 s45, s30, 13
	s_lshl_b32 s46, s28, 8
	s_add_u32 s45, s45, s46
	s_lshl_b32 s46, s31, 6
	s_add_u32 s45, s45, s46
	s_add_u32 s45, s45, 131072
	s_waitcnt lgkmcnt(0)
	v_add_f32 v32, v32, v36
	v_add_f32 v33, v33, v37
	v_add_f32 v34, v34, v38
	v_add_f32 v35, v35, v39
	v_add_f32 v32, v32, v33
	v_add_f32 v34, v34, v35
	v_add_f32 v57, v32, v34
	s_mov_b64 exec, 0xffff
	s_cmp_eq_u32 s79, 1
	s_cbranch_scc0 L_ds_25
	buffer_store_dwordx4 v[56:59], v24, s[40:43], s45 offen
	s_branch L_dsd_26
L_ds_25:
	buffer_store_dwordx4 v[56:59], v24, s[40:43], s45 offen sc1
L_dsd_26:
	s_mov_b64 exec, -1
L_noml:
	s_setprio 0
	ds_read_b128 v[64:67], v14 offset:0
	ds_read_b128 v[68:71], v14 offset:64
	ds_read_b128 v[72:75], v14 offset:128
	ds_read_b128 v[76:79], v14 offset:192
	ds_read_b128 v[80:83], v14 offset:256
	ds_read_b128 v[84:87], v14 offset:320
	ds_read_b128 v[88:91], v14 offset:384
	ds_read_b128 v[92:95], v14 offset:448
	s_waitcnt lgkmcnt(0)
	ds_read_b128 v[96:99], v14 offset:512
	ds_read_b128 v[100:103], v14 offset:576
	ds_read_b128 v[104:107], v14 offset:640
	ds_read_b128 v[108:111], v14 offset:704
	ds_read_b128 v[112:115], v14 offset:768
	ds_read_b128 v[116:119], v14 offset:832
	ds_read_b128 v[120:123], v14 offset:896
	ds_read_b128 v[124:127], v14 offset:960
	v_mov_b32 v52, 0
	v_mov_b32 v53, 0
	s_mov_b32 s46, 262144
L_w4_27:
	ds_read_b128 v[44:47], v5 offset:32
	s_waitcnt lgkmcnt(0)
	v_min3_u32 v44, v44, v45, v46
	v_min_u32 v44, v44, v47
	s_nop 0
	v_readfirstlane_b32 s47, v44
	s_nop 0
	s_cmp_ge_u32 s47, 23
	s_cbranch_scc1 L_w4d_28
	s_sub_u32 s46, s46, 1
	s_cbranch_scc1 L_w4d_28
	s_sleep 4
	s_branch L_w4_27
L_w4d_28:
	ds_read_b64_tr_b16 v[24:25], v15 offset:0
	ds_read_b64_tr_b16 v[26:27], v15 offset:1024
	ds_read_b64_tr_b16 v[28:29], v15 offset:8192
	ds_read_b64_tr_b16 v[30:31], v15 offset:9216
	ds_read_b64_tr_b16 v[32:33], v15 offset:16384
	ds_read_b64_tr_b16 v[34:35], v15 offset:17408
	ds_read_b64_tr_b16 v[36:37], v15 offset:24576
	ds_read_b64_tr_b16 v[38:39], v15 offset:25600
	s_waitcnt lgkmcnt(6)
	v_mfma_f32_16x16x32_bf16 v[40:43], v[24:27], v[64:67], 0
	s_waitcnt lgkmcnt(4)
	v_mfma_f32_16x16x32_bf16 v[40:43], v[28:31], v[68:71], v[40:43]
	s_waitcnt lgkmcnt(2)
	v_mfma_f32_16x16x32_bf16 v[40:43], v[32:35], v[72:75], v[40:43]
	s_waitcnt lgkmcnt(0)
	v_mfma_f32_16x16x32_bf16 v[40:43], v[36:39], v[76:79], v[40:43]
	s_mov_b32 s46, 262144
L_w4_29:
	ds_read_b128 v[44:47], v5 offset:32
	s_waitcnt lgkmcnt(0)
	v_min3_u32 v44, v44, v45, v46
	v_min_u32 v44, v44, v47
	s_nop 0
	v_readfirstlane_b32 s47, v44
	s_nop 0
	s_cmp_ge_u32 s47, 27
	s_cbranch_scc1 L_w4d_30
	s_sub_u32 s46, s46, 1
	s_cbranch_scc1 L_w4d_30
	s_sleep 4
	s_branch L_w4_29
L_w4d_30:
	ds_read_b64_tr_b16 v[24:25], v15 offset:32768
	ds_read_b64_tr_b16 v[26:27], v15 offset:33792
	ds_read_b64_tr_b16 v[28:29], v15 offset:40960
	ds_read_b64_tr_b16 v[30:31], v15 offset:41984
	ds_read_b64_tr_b16 v[32:33], v15 offset:49152
	ds_read_b64_tr_b16 v[34:35], v15 offset:50176
	ds_read_b64_tr_b16 v[36:37], v15 offset:57344
	ds_read_b64_tr_b16 v[38:39], v15 offset:58368
	s_waitcnt lgkmcnt(6)
	v_mfma_f32_16x16x32_bf16 v[40:43], v[24:27], v[80:83], v[40:43]
	s_waitcnt lgkmcnt(4)
	v_mfma_f32_16x16x32_bf16 v[40:43], v[28:31], v[84:87], v[40:43]
	s_waitcnt lgkmcnt(2)
	v_mfma_f32_16x16x32_bf16 v[40:43], v[32:35], v[88:91], v[40:43]
	s_waitcnt lgkmcnt(0)
	v_mfma_f32_16x16x32_bf16 v[40:43], v[36:39], v[92:95], v[40:43]
	s_mov_b32 s46, 262144
L_w4_31:
	ds_read_b128 v[44:47], v5 offset:32
	s_waitcnt lgkmcnt(0)
	v_min3_u32 v44, v44, v45, v46
	v_min_u32 v44, v44, v47
	s_nop 0
	v_readfirstlane_b32 s47, v44
	s_nop 0
	s_cmp_ge_u32 s47, 31
	s_cbranch_scc1 L_w4d_32
	s_sub_u32 s46, s46, 1
	s_cbranch_scc1 L_w4d_32
	s_sleep 4
	s_branch L_w4_31
L_w4d_32:
	ds_read_b64_tr_b16 v[24:25], v16 offset:0
	ds_read_b64_tr_b16 v[26:27], v16 offset:1024
	ds_read_b64_tr_b16 v[28:29], v16 offset:8192
	ds_read_b64_tr_b16 v[30:31], v16 offset:9216
	ds_read_b64_tr_b16 v[32:33], v16 offset:16384
	ds_read_b64_tr_b16 v[34:35], v16 offset:17408
	ds_read_b64_tr_b16 v[36:37], v16 offset:24576
	ds_read_b64_tr_b16 v[38:39], v16 offset:25600
	s_waitcnt lgkmcnt(6)
	v_mfma_f32_16x16x32_bf16 v[40:43], v[24:27], v[96:99], v[40:43]
	s_waitcnt lgkmcnt(4)
	v_mfma_f32_16x16x32_bf16 v[40:43], v[28:31], v[100:103], v[40:43]
	s_waitcnt lgkmcnt(2)
	v_mfma_f32_16x16x32_bf16 v[40:43], v[32:35], v[104:107], v[40:43]
	s_waitcnt lgkmcnt(0)
	v_mfma_f32_16x16x32_bf16 v[40:43], v[36:39], v[108:111], v[40:43]
	s_mov_b32 s46, 262144
L_w4_33:
	ds_read_b128 v[44:47], v5 offset:32
	s_waitcnt lgkmcnt(0)
	v_min3_u32 v44, v44, v45, v46
	v_min_u32 v44, v44, v47
	s_nop 0
	v_readfirstlane_b32 s47, v44
	s_nop 0
	s_cmp_ge_u32 s47, 33
	s_cbranch_scc1 L_w4d_34
	s_sub_u32 s46, s46, 1
	s_cbranch_scc1 L_w4d_34
	s_sleep 1
	s_branch L_w4_33
L_w4d_34:
	ds_read_b64_tr_b16 v[24:25], v16 offset:32768
	ds_read_b64_tr_b16 v[26:27], v16 offset:33792
	ds_read_b64_tr_b16 v[28:29], v16 offset:40960
	ds_read_b64_tr_b16 v[30:31], v16 offset:41984
	s_waitcnt lgkmcnt(2)
	v_mfma_f32_16x16x32_bf16 v[40:43], v[24:27], v[112:115], v[40:43]
	s_waitcnt lgkmcnt(0)
	v_mfma_f32_16x16x32_bf16 v[40:43], v[28:31], v[116:119], v[40:43]
	s_setprio 3
	s_barrier
	ds_read_b64_tr_b16 v[24:25], v16 offset:49152
	ds_read_b64_tr_b16 v[26:27], v16 offset:50176
	ds_read_b64_tr_b16 v[28:29], v16 offset:57344
	ds_read_b64_tr_b16 v[30:31], v16 offset:58368
	ds_read_b32 v62, v50
	s_waitcnt lgkmcnt(3)
	v_mfma_f32_16x16x32_bf16 v[40:43], v[24:27], v[120:123], v[40:43]
	s_waitcnt lgkmcnt(1)
	v_mfma_f32_16x16x32_bf16 v[40:43], v[28:31], v[124:127], v[40:43]
	s_waitcnt lgkmcnt(0)
	s_nop 6
	v_mul_f32 v40, v40, v62
	v_mul_f32 v41, v41, v62
	v_mul_f32 v42, v42, v62
	v_mul_f32 v43, v43, v62
	v_cvt_pk_bf16_f32 v56, v40, v41
	v_cvt_pk_bf16_f32 v57, v42, v43
	s_mov_b32 exec_lo, 0x000f000f
	s_mov_b32 exec_hi, 0x000f000f
	s_cmp_eq_u32 s79, 1
	s_cbranch_scc0 L_ds_35
	buffer_store_dwordx4 v[56:59], v48, s[40:43], s54 offen
	s_branch L_dsd_36
L_ds_35:
	buffer_store_dwordx4 v[56:59], v48, s[40:43], s54 offen sc1
L_dsd_36:
	s_mov_b64 exec, -1
	s_cmp_lg_u32 s56, 2
	s_cbranch_scc1 L_nofb
	ds_read_b64 v[52:53], v51
L_nofb:
	s_barrier
	ds_read_b64_tr_b16 v[64:65], v17 offset:0
	ds_read_b64_tr_b16 v[66:67], v17 offset:1024
	ds_read_b128 v[72:75], v23 offset:0
	ds_read_b128 v[76:79], v23 offset:2048
	ds_read_b64_tr_b16 v[68:69], v17 offset:8192
	ds_read_b64_tr_b16 v[70:71], v17 offset:9216
	ds_read_b128 v[80:83], v23 offset:1024
	ds_read_b128 v[84:87], v23 offset:3072
	s_waitcnt lgkmcnt(4)
	v_mfma_f32_16x16x32_bf16 v[40:43], v[64:67], v[72:75], 0
	v_mfma_f32_16x16x32_bf16 v[40:43], v[64:67], v[76:79], v[40:43]
	s_waitcnt lgkmcnt(0)
	v_mfma_f32_16x16x32_bf16 v[40:43], v[68:71], v[80:83], v[40:43]
	v_mfma_f32_16x16x32_bf16 v[40:43], v[68:71], v[84:87], v[40:43]
	s_nop 7
	v_add_f32_dpp v40, v40, v40 row_ror:8 row_mask:0xf bank_mask:0xf
	v_add_f32_dpp v41, v41, v41 row_ror:8 row_mask:0xf bank_mask:0xf
	v_add_f32_dpp v42, v42, v42 row_ror:8 row_mask:0xf bank_mask:0xf
	v_add_f32_dpp v43, v43, v43 row_ror:8 row_mask:0xf bank_mask:0xf
	v_cndmask_b32 v56, v40, v42, s[48:49]
	v_cndmask_b32 v57, v41, v43, s[48:49]
	v_add_f32 v56, v56, v52
	v_add_f32 v57, v57, v53
	buffer_store_dwordx4 v[56:59], v49, s[40:43], s58 offen sc1
	s_setprio 0
	s_barrier
	s_branch L_fin
L_ctrl:
	s_setprio 3
	s_barrier
	s_waitcnt lgkmcnt(0)
	s_add_u32 s26, s26, 16
	s_andn2_b32 s26, s26, 15
	s_add_u32 s27, s27, 0x9E3779B9
	v_mov_b32 v60, s26
	v_mov_b32 v61, s27
	s_add_u32 s72, s28, 0
	s_and_b32 s72, s72, 7
	s_cmp_eq_u32 s3, 1
	s_cbranch_scc1 L_ffn
	s_cmp_eq_u32 s3, 7
	s_cbranch_scc1 L_qgather
	s_cmp_eq_u32 s3, 0
	s_cbranch_scc1 L_qtile
	s_getreg_b32 s22, hwreg(HW_REG_XCC_ID)
	s_and_b32 s22, s22, 15
	s_add_u32 s22, s22, s26
	s_mov_b32 s23, s22
	v_mov_b32 v8, 0
	v_mov_b32 v9, s22
	v_lshlrev_b32 v10, 2, v0
	s_mul_i32 s45, s28, 4352
	s_add_u32 s45, s45, 4718592
	s_lshl_b32 s46, s29, 2
	s_add_u32 s46, s46, s45
	s_mov_b64 exec, 1
	buffer_store_dword v9, v8, s[40:43], s46 offen
	s_mov_b32 exec_lo, -1
	s_mov_b32 s46, 32
	s_mov_b32 s0, 2
L_xt:
	buffer_load_dword v11, v10, s[40:43], s45 offen sc1
	s_waitcnt vmcnt(0)
	v_cmp_eq_u32 vcc, s22, v11
	s_nop 0
	s_cmp_eq_u64 vcc, exec
	s_cbranch_scc1 L_xtok
	s_sub_u32 s46, s46, 1
	s_cbranch_scc1 L_xtd
	s_sleep 2
	s_branch L_xt
L_xtok:
	s_mov_b32 s0, 1
L_xtd:
	s_mov_b64 exec, -1
	v_mov_b32 v9, s0
	ds_write_b32 v5, v9 offset:24
	s_waitcnt lgkmcnt(0)
	s_branch L_fin
L_qtile:
	s_lshl_b32 s45, s72, 16
	s_lshl_b32 s50, s31, 11
	s_add_u32 s45, s45, s50
	s_lshl_b32 s50, s30, 8
	s_add_u32 s45, s45, s50
	s_add_u32 s45, s45, 524288
	s_mul_i32 s50, s72, 4352
	s_lshl_b32 s51, s29, 2
	s_add_u32 s50, s50, s51
	s_add_u32 s50, s50, 4194304
	v_lshl_add_u32 v8, v1, 3, v3
	v_lshlrev_b32 v8, 7, v8
	v_lshl_add_u32 v8, v4, 3, v8
	v_add_u32 v8, 131072, v8
	v_and_b32 v41, 7, v2
	s_movk_i32 s48, 1040
	v_mul_lo_u32 v9, v41, s48
	v_lshl_add_u32 v9, v1, 4, v9
	s_lshl_b32 s48, s31, 8
	s_add_u32 s48, s48, 147456
	v_add_u32 v9, s48, v9
	v_lshlrev_b32 v41, 13, v41
	v_lshl_add_u32 v41, v1, 4, v41
	v_lshrrev_b32 v42, 3, v2
	v_lshl_add_u32 v41, v42, 6, v41
	s_mov_b32 s48, 0xff00ff00
	s_mov_b32 s49, 0xff00ff00
	v_mov_b32 v43, 0
	s_mov_b32 s46, 262144
L_fw_37:
	ds_read_b32 v7, v5 offset:0
	s_waitcnt lgkmcnt(0)
	v_readfirstlane_b32 s47, v7
	s_nop 0
	s_cmp_ge_u32 s47, 8
	s_cbranch_scc1 L_fwd_38
	s_sub_u32 s46, s46, 1
	s_cbranch_scc1 L_fwd_38
	s_sleep 1
	s_branch L_fw_37
L_fwd_38:
	ds_read_b128 v[16:19], v9 offset:0
	ds_read_b128 v[20:23], v9 offset:64
	ds_read_b128 v[24:27], v9 offset:128
	ds_read_b128 v[28:31], v9 offset:192
	ds_read_b64_tr_b16 v[64:65], v8 offset:0
	ds_read_b64_tr_b16 v[66:67], v8 offset:512
	ds_read_b64_tr_b16 v[68:69], v8 offset:4096
	ds_read_b64_tr_b16 v[70:71], v8 offset:4608
	ds_read_b64_tr_b16 v[72:73], v8 offset:8192
	ds_read_b64_tr_b16 v[74:75], v8 offset:8704
	ds_read_b64_tr_b16 v[76:77], v8 offset:12288
	ds_read_b64_tr_b16 v[78:79], v8 offset:12800
	s_waitcnt lgkmcnt(0)
	ds_read_b64_tr_b16 v[80:81], v8 offset:32
	ds_read_b64_tr_b16 v[82:83], v8 offset:544
	ds_read_b64_tr_b16 v[84:85], v8 offset:4128
	ds_read_b64_tr_b16 v[86:87], v8 offset:4640
	ds_read_b64_tr_b16 v[88:89], v8 offset:8224
	ds_read_b64_tr_b16 v[90:91], v8 offset:8736
	ds_read_b64_tr_b16 v[92:93], v8 offset:12320
	ds_read_b64_tr_b16 v[94:95], v8 offset:12832
	s_waitcnt lgkmcnt(0)
	ds_read_b64_tr_b16 v[96:97], v8 offset:64
	ds_read_b64_tr_b16 v[98:99], v8 offset:576
	ds_read_b64_tr_b16 v[100:101], v8 offset:4160
	ds_read_b64_tr_b16 v[102:103], v8 offset:4672
	ds_read_b64_tr_b16 v[104:105], v8 offset:8256
	ds_read_b64_tr_b16 v[106:107], v8 offset:8768
	ds_read_b64_tr_b16 v[108:109], v8 offset:12352
	ds_read_b64_tr_b16 v[110:111], v8 offset:12864
	s_waitcnt lgkmcnt(0)
	ds_read_b64_tr_b16 v[112:113], v8 offset:96
	ds_read_b64_tr_b16 v[114:115], v8 offset:608
	ds_read_b64_tr_b16 v[116:117], v8 offset:4192
	ds_read_b64_tr_b16 v[118:119], v8 offset:4704
	ds_read_b64_tr_b16 v[120:121], v8 offset:8288
	ds_read_b64_tr_b16 v[122:123], v8 offset:8800
	ds_read_b64_tr_b16 v[124:125], v8 offset:12384
	ds_read_b64_tr_b16 v[126:127], v8 offset:12896
	s_waitcnt lgkmcnt(0)
	s_mov_b64 exec, 1
	ds_add_u32 v5, v6 offset:4
	s_mov_b64 exec, -1
	v_mfma_f32_16x16x32_bf16 v[32:35], v[64:67], v[16:19], 0
	v_mfma_f32_16x16x32_bf16 v[36:39], v[80:83], v[16:19], 0
	v_mfma_f32_16x16x32_bf16 v[12:15], v[96:99], v[16:19], 0
	v_mfma_f32_16x16x32_bf16 v[8:11], v[112:115], v[16:19], 0
	v_mfma_f32_16x16x32_bf16 v[32:35], v[68:71], v[20:23], v[32:35]
	v_mfma_f32_16x16x32_bf16 v[36:39], v[84:87], v[20:23], v[36:39]
	v_mfma_f32_16x16x32_bf16 v[12:15], v[100:103], v[20:23], v[12:15]
	v_mfma_f32_16x16x32_bf16 v[8:11], v[116:119], v[20:23], v[8:11]
	v_mfma_f32_16x16x32_bf16 v[32:35], v[72:75], v[24:27], v[32:35]
	v_mfma_f32_16x16x32_bf16 v[36:39], v[88:91], v[24:27], v[36:39]
	v_mfma_f32_16x16x32_bf16 v[12:15], v[104:107], v[24:27], v[12:15]
	v_mfma_f32_16x16x32_bf16 v[8:11], v[120:123], v[24:27], v[8:11]
	v_mfma_f32_16x16x32_bf16 v[32:35], v[76:79], v[28:31], v[32:35]
	v_mfma_f32_16x16x32_bf16 v[36:39], v[92:95], v[28:31], v[36:39]
	v_mfma_f32_16x16x32_bf16 v[12:15], v[108:111], v[28:31], v[12:15]
	v_mfma_f32_16x16x32_bf16 v[8:11], v[124:127], v[28:31], v[8:11]
	s_nop 5
	v_cndmask_b32 v44, v32, v36, s[48:49]
	v_cndmask_b32 v45, v33, v37, s[48:49]
	v_cndmask_b32 v46, v34, v38, s[48:49]
	v_cndmask_b32 v47, v35, v39, s[48:49]
	buffer_store_dwordx4 v[44:47], v41, s[40:43], s45 offen offset:0
	v_cndmask_b32 v48, v12, v8, s[48:49]
	v_cndmask_b32 v49, v13, v9, s[48:49]
	v_cndmask_b32 v50, v14, v10, s[48:49]
	v_cndmask_b32 v51, v15, v11, s[48:49]
	buffer_store_dwordx4 v[48:51], v41, s[40:43], s45 offen offset:128
	s_mov_b32 s46, 262144
L_fw_39:
	ds_read_b32 v7, v5 offset:24
	s_waitcnt lgkmcnt(0)
	v_readfirstlane_b32 s47, v7
	s_nop 0
	s_cmp_ge_u32 s47, 1
	s_cbranch_scc1 L_fwd_40
	s_sub_u32 s46, s46, 1
	s_cbranch_scc1 L_fwd_40
	s_sleep 1
	s_branch L_fw_39
L_fwd_40:
	s_mov_b32 s79, s47
	s_cmp_eq_u32 s79, 1
	s_cbranch_scc1 L_lg_41
	buffer_store_dwordx4 v[44:47], v41, s[40:43], s45 offen offset:0 sc1
	buffer_store_dwordx4 v[48:51], v41, s[40:43], s45 offen offset:128 sc1
L_lg_41:
	s_waitcnt vmcnt(0)
	s_mov_b64 exec, 1
	s_cmp_eq_u32 s79, 1
	s_cbranch_scc0 L_ds_42
	buffer_store_dword v60, v43, s[40:43], s50 offen
	s_branch L_dsd_43
L_ds_42:
	buffer_store_dword v60, v43, s[40:43], s50 offen sc1
L_dsd_43:
	s_mov_b64 exec, -1
	s_mov_b64 exec, 1
	ds_add_u32 v5, v6 offset:12
	s_mov_b64 exec, -1
	s_lshl_b32 s21, s2, 8
	s_add_u32 s21, s21, 131072
	s_add_u32 s22, s24, s21
	s_addc_u32 s23, s25, 0
	v_lshlrev_b32 v10, 2, v4
	v_add_u32 v10, 161536, v10
	s_setprio 0
	s_mov_b32 s46, 262144
L_fw_44:
	ds_read_b32 v7, v5 offset:20
	s_waitcnt lgkmcnt(0)
	v_readfirstlane_b32 s47, v7
	s_nop 0
	s_cmp_ge_u32 s47, 8
	s_cbranch_scc1 L_fwd_45
	s_sub_u32 s46, s46, 1
	s_cbranch_scc1 L_fwd_45
	s_sleep 8
	s_branch L_fw_44
L_fwd_45:
	s_setprio 3
	v_lshlrev_b32 v9, 4, v0
	s_mov_b64 exec, 0xffff
	s_mov_b32 s46, 16384
L_pl_46:
	buffer_load_dwordx4 v[16:19], v9, s[40:43], s21 offen sc1
	s_waitcnt vmcnt(0)
	v_cmp_eq_u64 vcc, s[26:27], v[18:19]
	s_nop 0
	s_cmp_eq_u64 vcc, exec
	s_cbranch_scc1 L_pld_47
	s_sub_u32 s46, s46, 1
	s_cbranch_scc1 L_pld_47
	s_sleep 1
	s_branch L_pl_46
L_pld_47:
	v_max_f32_dpp v20, v16, v16 row_ror:4 row_mask:0xf bank_mask:0xf
	s_nop 1
	v_max_f32_dpp v20, v20, v20 row_ror:8 row_mask:0xf bank_mask:0xf
	v_sub_f32 v20, v16, v20
	v_mul_f32 v20, 0x3fb8aa3b, v20
	v_exp_f32 v20, v20
	s_nop 0
	v_mul_f32 v21, v20, v17
	s_nop 1
	v_add_f32_dpp v21, v21, v21 row_ror:4 row_mask:0xf bank_mask:0xf
	s_nop 1
	v_add_f32_dpp v21, v21, v21 row_ror:8 row_mask:0xf bank_mask:0xf
	v_rcp_f32 v21, v21
	s_nop 0
	v_mul_f32 v20, v20, v21
	s_lshl_b32 s45, s31, 2
	s_lshl_b64 exec, 0xf, s45
	ds_write_b32 v10, v20
	s_waitcnt lgkmcnt(0)
	s_branch L_fin
L_ffn:
	s_cmp_eq_u32 s56, 2
	s_cbranch_scc1 L_ffn2
	s_cmp_eq_u32 s56, 1
	s_cbranch_scc1 L_ffn1
	s_mov_b64 exec, 1
	ds_add_u32 v5, v6 offset:4
	s_mov_b64 exec, -1
	s_branch L_fin
L_ffn1:
	s_lshl_b32 s45, s57, 13
	s_lshl_b32 s50, s31, 11
	s_add_u32 s45, s45, s50
	s_add_u32 s45, s45, 262144
	s_mul_i32 s50, s57, 4352
	s_lshl_b32 s51, s31, 2
	s_add_u32 s50, s50, s51
	s_add_u32 s50, s50, 4521984
	v_lshl_add_u32 v8, v1, 3, v3
	v_lshlrev_b32 v8, 7, v8
	v_lshl_add_u32 v8, v4, 3, v8
	v_add_u32 v8, 114688, v8
	v_and_b32 v41, 7, v2
	s_movk_i32 s48, 1040
	v_mul_lo_u32 v9, v41, s48
	v_lshl_add_u32 v9, v1, 4, v9
	s_lshl_b32 s48, s31, 8
	s_add_u32 s48, s48, 147456
	v_add_u32 v9, s48, v9
	v_lshlrev_b32 v41, 8, v41
	v_lshl_add_u32 v41, v1, 4, v41
	v_lshrrev_b32 v42, 3, v2
	v_lshl_add_u32 v41, v42, 6, v41
	s_mov_b32 s48, 0xff00ff00
	s_mov_b32 s49, 0xff00ff00
	v_mov_b32 v43, 0
	s_mov_b32 s46, 262144
L_fw_48:
	ds_read_b32 v7, v5 offset:0
	s_waitcnt lgkmcnt(0)
	v_readfirstlane_b32 s47, v7
	s_nop 0
	s_cmp_ge_u32 s47, 8
	s_cbranch_scc1 L_fwd_49
	s_sub_u32 s46, s46, 1
	s_cbranch_scc1 L_fwd_49
	s_sleep 1
	s_branch L_fw_48
L_fwd_49:
	ds_read_b128 v[16:19], v9 offset:0
	ds_read_b128 v[20:23], v9 offset:64
	ds_read_b128 v[24:27], v9 offset:128
	ds_read_b128 v[28:31], v9 offset:192
	ds_read_b64_tr_b16 v[64:65], v8 offset:0
	ds_read_b64_tr_b16 v[66:67], v8 offset:512
	ds_read_b64_tr_b16 v[68:69], v8 offset:4096
	ds_read_b64_tr_b16 v[70:71], v8 offset:4608
	ds_read_b64_tr_b16 v[72:73], v8 offset:8192
	ds_read_b64_tr_b16 v[74:75], v8 offset:8704
	ds_read_b64_tr_b16 v[76:77], v8 offset:12288
	ds_read_b64_tr_b16 v[78:79], v8 offset:12800
	s_waitcnt lgkmcnt(0)
	ds_read_b64_tr_b16 v[80:81], v8 offset:32
	ds_read_b64_tr_b16 v[82:83], v8 offset:544
	ds_read_b64_tr_b16 v[84:85], v8 offset:4128
	ds_read_b64_tr_b16 v[86:87], v8 offset:4640
	ds_read_b64_tr_b16 v[88:89], v8 offset:8224
	ds_read_b64_tr_b16 v[90:91], v8 offset:8736
	ds_read_b64_tr_b16 v[92:93], v8 offset:12320
	ds_read_b64_tr_b16 v[94:95], v8 offset:12832
	s_waitcnt lgkmcnt(0)
	ds_read_b64_tr_b16 v[96:97], v8 offset:64
	ds_read_b64_tr_b16 v[98:99], v8 offset:576
	ds_read_b64_tr_b16 v[100:101], v8 offset:4160
	ds_read_b64_tr_b16 v[102:103], v8 offset:4672
	ds_read_b64_tr_b16 v[104:105], v8 offset:8256
	ds_read_b64_tr_b16 v[106:107], v8 offset:8768
	ds_read_b64_tr_b16 v[108:109], v8 offset:12352
	ds_read_b64_tr_b16 v[110:111], v8 offset:12864
	s_waitcnt lgkmcnt(0)
	ds_read_b64_tr_b16 v[112:113], v8 offset:96
	ds_read_b64_tr_b16 v[114:115], v8 offset:608
	ds_read_b64_tr_b16 v[116:117], v8 offset:4192
	ds_read_b64_tr_b16 v[118:119], v8 offset:4704
	ds_read_b64_tr_b16 v[120:121], v8 offset:8288
	ds_read_b64_tr_b16 v[122:123], v8 offset:8800
	ds_read_b64_tr_b16 v[124:125], v8 offset:12384
	ds_read_b64_tr_b16 v[126:127], v8 offset:12896
	s_waitcnt lgkmcnt(0)
	s_mov_b64 exec, 1
	ds_add_u32 v5, v6 offset:4
	s_mov_b64 exec, -1
	v_mfma_f32_16x16x32_bf16 v[32:35], v[64:67], v[16:19], 0
	v_mfma_f32_16x16x32_bf16 v[36:39], v[80:83], v[16:19], 0
	v_mfma_f32_16x16x32_bf16 v[12:15], v[96:99], v[16:19], 0
	v_mfma_f32_16x16x32_bf16 v[8:11], v[112:115], v[16:19], 0
	v_mfma_f32_16x16x32_bf16 v[32:35], v[68:71], v[20:23], v[32:35]
	v_mfma_f32_16x16x32_bf16 v[36:39], v[84:87], v[20:23], v[36:39]
	v_mfma_f32_16x16x32_bf16 v[12:15], v[100:103], v[20:23], v[12:15]
	v_mfma_f32_16x16x32_bf16 v[8:11], v[116:119], v[20:23], v[8:11]
	v_mfma_f32_16x16x32_bf16 v[32:35], v[72:75], v[24:27], v[32:35]
	v_mfma_f32_16x16x32_bf16 v[36:39], v[88:91], v[24:27], v[36:39]
	v_mfma_f32_16x16x32_bf16 v[12:15], v[104:107], v[24:27], v[12:15]
	v_mfma_f32_16x16x32_bf16 v[8:11], v[120:123], v[24:27], v[8:11]
	v_mfma_f32_16x16x32_bf16 v[32:35], v[76:79], v[28:31], v[32:35]
	v_mfma_f32_16x16x32_bf16 v[36:39], v[92:95], v[28:31], v[36:39]
	v_mfma_f32_16x16x32_bf16 v[12:15], v[108:111], v[28:31], v[12:15]
	v_mfma_f32_16x16x32_bf16 v[8:11], v[124:127], v[28:31], v[8:11]
	s_nop 5
	v_cndmask_b32 v44, v32, v36, s[48:49]
	v_cndmask_b32 v45, v33, v37, s[48:49]
	v_cndmask_b32 v46, v34, v38, s[48:49]
	v_cndmask_b32 v47, v35, v39, s[48:49]
	buffer_store_dwordx4 v[44:47], v41, s[40:43], s45 offen offset:0
	v_cndmask_b32 v48, v12, v8, s[48:49]
	v_cndmask_b32 v49, v13, v9, s[48:49]
	v_cndmask_b32 v50, v14, v10, s[48:49]
	v_cndmask_b32 v51, v15, v11, s[48:49]
	buffer_store_dwordx4 v[48:51], v41, s[40:43], s45 offen offset:128
	s_mov_b32 s46, 262144
L_fw_50:
	ds_read_b32 v7, v5 offset:24
	s_waitcnt lgkmcnt(0)
	v_readfirstlane_b32 s47, v7
	s_nop 0
	s_cmp_ge_u32 s47, 1
	s_cbranch_scc1 L_fwd_51
	s_sub_u32 s46, s46, 1
	s_cbranch_scc1 L_fwd_51
	s_sleep 1
	s_branch L_fw_50
L_fwd_51:
	s_mov_b32 s79, s47
	s_cmp_eq_u32 s79, 1
	s_cbranch_scc1 L_lg_52
	buffer_store_dwordx4 v[44:47], v41, s[40:43], s45 offen offset:0 sc1
	buffer_store_dwordx4 v[48:51], v41, s[40:43], s45 offen offset:128 sc1
L_lg_52:
	s_waitcnt vmcnt(0)
	s_mov_b64 exec, 1
	s_cmp_eq_u32 s79, 1
	s_cbranch_scc0 L_ds_53
	buffer_store_dword v60, v43, s[40:43], s50 offen
	s_branch L_dsd_54
L_ds_53:
	buffer_store_dword v60, v43, s[40:43], s50 offen sc1
L_dsd_54:
	s_mov_b64 exec, -1
	s_branch L_fin
L_ffn2:
	v_and_b32 v8, 1, v1
	v_lshl_add_u32 v8, v8, 2, v3
	v_lshl_add_u32 v9, v1, 3, v3
	v_lshlrev_b32 v9, 8, v9
	v_lshl_add_u32 v9, v4, 3, v9
	v_add_u32 v9, 114688, v9
	s_mov_b32 s46, 262144
L_fw_55:
	ds_read_b32 v7, v5 offset:0
	s_waitcnt lgkmcnt(0)
	v_readfirstlane_b32 s47, v7
	s_nop 0
	s_cmp_ge_u32 s47, 8
	s_cbranch_scc1 L_fwd_56
	s_sub_u32 s46, s46, 1
	s_cbranch_scc1 L_fwd_56
	s_sleep 1
	s_branch L_fw_55
L_fwd_56:
	v_xor_b32 v10, 0, v8
	v_lshl_add_u32 v10, v10, 5, v9
	ds_read_b64_tr_b16 v[64:65], v10 offset:0
	ds_read_b64_tr_b16 v[66:67], v10 offset:1024
	ds_read_b64_tr_b16 v[68:69], v10 offset:8192
	ds_read_b64_tr_b16 v[70:71], v10 offset:9216
	v_xor_b32 v10, 1, v8
	v_lshl_add_u32 v10, v10, 5, v9
	ds_read_b64_tr_b16 v[72:73], v10 offset:0
	ds_read_b64_tr_b16 v[74:75], v10 offset:1024
	ds_read_b64_tr_b16 v[76:77], v10 offset:8192
	ds_read_b64_tr_b16 v[78:79], v10 offset:9216
	s_waitcnt lgkmcnt(0)
	v_xor_b32 v10, 2, v8
	v_lshl_add_u32 v10, v10, 5, v9
	ds_read_b64_tr_b16 v[80:81], v10 offset:0
	ds_read_b64_tr_b16 v[82:83], v10 offset:1024
	ds_read_b64_tr_b16 v[84:85], v10 offset:8192
	ds_read_b64_tr_b16 v[86:87], v10 offset:9216
	v_xor_b32 v10, 3, v8
	v_lshl_add_u32 v10, v10, 5, v9
	ds_read_b64_tr_b16 v[88:89], v10 offset:0
	ds_read_b64_tr_b16 v[90:91], v10 offset:1024
	ds_read_b64_tr_b16 v[92:93], v10 offset:8192
	ds_read_b64_tr_b16 v[94:95], v10 offset:9216
	s_waitcnt lgkmcnt(0)
	v_xor_b32 v10, 4, v8
	v_lshl_add_u32 v10, v10, 5, v9
	ds_read_b64_tr_b16 v[96:97], v10 offset:0
	ds_read_b64_tr_b16 v[98:99], v10 offset:1024
	ds_read_b64_tr_b16 v[100:101], v10 offset:8192
	ds_read_b64_tr_b16 v[102:103], v10 offset:9216
	v_xor_b32 v10, 5, v8
	v_lshl_add_u32 v10, v10, 5, v9
	ds_read_b64_tr_b16 v[104:105], v10 offset:0
	ds_read_b64_tr_b16 v[106:107], v10 offset:1024
	ds_read_b64_tr_b16 v[108:109], v10 offset:8192
	ds_read_b64_tr_b16 v[110:111], v10 offset:9216
	s_waitcnt lgkmcnt(0)
	v_xor_b32 v10, 6, v8
	v_lshl_add_u32 v10, v10, 5, v9
	ds_read_b64_tr_b16 v[112:113], v10 offset:0
	ds_read_b64_tr_b16 v[114:115], v10 offset:1024
	ds_read_b64_tr_b16 v[116:117], v10 offset:8192
	ds_read_b64_tr_b16 v[118:119], v10 offset:9216
	v_xor_b32 v10, 7, v8
	v_lshl_add_u32 v10, v10, 5, v9
	ds_read_b64_tr_b16 v[120:121], v10 offset:0
	ds_read_b64_tr_b16 v[122:123], v10 offset:1024
	ds_read_b64_tr_b16 v[124:125], v10 offset:8192
	ds_read_b64_tr_b16 v[126:127], v10 offset:9216
	s_waitcnt lgkmcnt(0)
	s_mov_b64 exec, 1
	ds_add_u32 v5, v6 offset:4
	s_mov_b64 exec, -1
	s_lshl_b32 s45, s57, 13
	s_add_u32 s45, s45, 262144
	s_mul_i32 s50, s57, 4352
	s_add_u32 s50, s50, 4521984
	s_mov_b32 s22, s26
	s_mov_b32 s23, s26
	s_movk_i32 s48, 144
	v_mul_lo_u32 v11, v1, s48
	v_lshl_add_u32 v11, v2, 3, v11
	v_add_u32 v11, 151552, v11
	v_and_b32 v56, 7, v2
	v_mul_lo_u32 v56, v56, s48
	v_lshl_add_u32 v56, v1, 4, v56
	v_add_u32 v56, 151552, v56
	s_mov_b32 s46, 262144
L_fw_57:
	ds_read_b32 v7, v5 offset:12
	s_waitcnt lgkmcnt(0)
	v_readfirstlane_b32 s47, v7
	s_nop 0
	s_cmp_ge_u32 s47, 1
	s_cbranch_scc1 L_fwd_58
	s_sub_u32 s46, s46, 1
	s_cbranch_scc1 L_fwd_58
	s_sleep 2
	s_branch L_fw_57
L_fwd_58:
	v_lshlrev_b32 v18, 2, v0
	s_mov_b64 exec, 0xf
	s_mov_b32 s46, 16384
L_vf_59:
	buffer_load_dword v16, v18, s[40:43], s50 offen sc1
	s_waitcnt vmcnt(0)
	v_cmp_eq_u32 vcc, s26, v16
	s_nop 0
	s_cmp_eq_u64 vcc, exec
	s_cbranch_scc1 L_vfd_60
	s_sub_u32 s46, s46, 1
	s_cbranch_scc1 L_vfd_60
	s_sleep 2
	s_branch L_vf_59
L_vfd_60:
	s_mov_b64 exec, -1
	v_lshlrev_b32 v10, 4, v0
	s_add_u32 s51, s45, 4096
	buffer_load_dwordx4 v[16:19], v10, s[40:43], s45 offen offset:0 sc1
	buffer_load_dwordx4 v[20:23], v10, s[40:43], s45 offen offset:1024 sc1
	buffer_load_dwordx4 v[24:27], v10, s[40:43], s45 offen offset:2048 sc1
	buffer_load_dwordx4 v[28:31], v10, s[40:43], s45 offen offset:3072 sc1
	buffer_load_dwordx4 v[32:35], v10, s[40:43], s51 offen offset:0 sc1
	buffer_load_dwordx4 v[36:39], v10, s[40:43], s51 offen offset:1024 sc1
	buffer_load_dwordx4 v[40:43], v10, s[40:43], s51 offen offset:2048 sc1
	buffer_load_dwordx4 v[44:47], v10, s[40:43], s51 offen offset:3072 sc1
	s_waitcnt vmcnt(0)
	v_add_f32 v16, v16, v24
	v_add_f32 v32, v32, v40
	v_add_f32 v16, v16, v32
	v_add_f32 v17, v17, v25
	v_add_f32 v33, v33, v41
	v_add_f32 v17, v17, v33
	v_add_f32 v18, v18, v26
	v_add_f32 v34, v34, v42
	v_add_f32 v18, v18, v34
	v_add_f32 v19, v19, v27
	v_add_f32 v35, v35, v43
	v_add_f32 v19, v19, v35
	v_add_f32 v20, v20, v28
	v_add_f32 v36, v36, v44
	v_add_f32 v20, v20, v36
	v_add_f32 v21, v21, v29
	v_add_f32 v37, v37, v45
	v_add_f32 v21, v21, v37
	v_add_f32 v22, v22, v30
	v_add_f32 v38, v38, v46
	v_add_f32 v22, v22, v38
	v_add_f32 v23, v23, v31
	v_add_f32 v39, v39, v47
	v_add_f32 v23, v23, v39
	v_max_f32 v16, 0, v16
	v_max_f32 v17, 0, v17
	v_max_f32 v18, 0, v18
	v_max_f32 v19, 0, v19
	v_max_f32 v20, 0, v20
	v_max_f32 v21, 0, v21
	v_max_f32 v22, 0, v22
	v_max_f32 v23, 0, v23
	v_cvt_pk_bf16_f32 v48, v16, v17
	v_cvt_pk_bf16_f32 v49, v18, v19
	v_cvt_pk_bf16_f32 v50, v20, v21
	v_cvt_pk_bf16_f32 v51, v22, v23
	ds_write_b64 v11, v[48:49]
	ds_write_b64 v11, v[50:51] offset:576
	ds_read_b128 v[16:19], v56
	ds_read_b128 v[20:23], v56 offset:64
	s_mov_b32 s48, 0xff00ff00
	s_mov_b32 s49, 0xff00ff00
	v_lshlrev_b32 v12, 3, v0
	v_add_u32 v12, 147456, v12
	s_waitcnt lgkmcnt(0)
	v_mfma_f32_16x16x32_bf16 v[32:35], v[64:67], v[16:19], 0
	v_mfma_f32_16x16x32_bf16 v[32:35], v[68:71], v[20:23], v[32:35]
	s_nop 7
	v_cndmask_b32 v44, v32, v34, s[48:49]
	v_cndmask_b32 v45, v33, v35, s[48:49]
	ds_write_b64 v12, v[44:45] offset:0
	v_mfma_f32_16x16x32_bf16 v[36:39], v[72:75], v[16:19], 0
	v_mfma_f32_16x16x32_bf16 v[36:39], v[76:79], v[20:23], v[36:39]
	s_nop 7
	v_cndmask_b32 v46, v36, v38, s[48:49]
	v_cndmask_b32 v47, v37, v39, s[48:49]
	ds_write_b64 v12, v[46:47] offset:512
	v_mfma_f32_16x16x32_bf16 v[32:35], v[80:83], v[16:19], 0
	v_mfma_f32_16x16x32_bf16 v[32:35], v[84:87], v[20:23], v[32:35]
	s_nop 7
	v_cndmask_b32 v48, v32, v34, s[48:49]
	v_cndmask_b32 v49, v33, v35, s[48:49]
	ds_write_b64 v12, v[48:49] offset:1024
	v_mfma_f32_16x16x32_bf16 v[36:39], v[88:91], v[16:19], 0
	v_mfma_f32_16x16x32_bf16 v[36:39], v[92:95], v[20:23], v[36:39]
	s_nop 7
	v_cndmask_b32 v50, v36, v38, s[48:49]
	v_cndmask_b32 v51, v37, v39, s[48:49]
	ds_write_b64 v12, v[50:51] offset:1536
	v_mfma_f32_16x16x32_bf16 v[32:35], v[96:99], v[16:19], 0
	v_mfma_f32_16x16x32_bf16 v[32:35], v[100:103], v[20:23], v[32:35]
	s_nop 7
	v_cndmask_b32 v44, v32, v34, s[48:49]
	v_cndmask_b32 v45, v33, v35, s[48:49]
	ds_write_b64 v12, v[44:45] offset:2048
	v_mfma_f32_16x16x32_bf16 v[36:39], v[104:107], v[16:19], 0
	v_mfma_f32_16x16x32_bf16 v[36:39], v[108:111], v[20:23], v[36:39]
	s_nop 7
	v_cndmask_b32 v46, v36, v38, s[48:49]
	v_cndmask_b32 v47, v37, v39, s[48:49]
	ds_write_b64 v12, v[46:47] offset:2560
	v_mfma_f32_16x16x32_bf16 v[32:35], v[112:115], v[16:19], 0
	v_mfma_f32_16x16x32_bf16 v[32:35], v[116:119], v[20:23], v[32:35]
	s_nop 7
	v_cndmask_b32 v48, v32, v34, s[48:49]
	v_cndmask_b32 v49, v33, v35, s[48:49]
	ds_write_b64 v12, v[48:49] offset:3072
	v_mfma_f32_16x16x32_bf16 v[36:39], v[120:123], v[16:19], 0
	v_mfma_f32_16x16x32_bf16 v[36:39], v[124:127], v[20:23], v[36:39]
	s_nop 7
	v_cndmask_b32 v50, v36, v38, s[48:49]
	v_cndmask_b32 v51, v37, v39, s[48:49]
	ds_write_b64 v12, v[50:51] offset:3584
	s_waitcnt lgkmcnt(0)
	s_branch L_fin
L_qgather:
	s_lshl_b32 s45, s28, 16
	s_lshl_b32 s50, s30, 13
	s_add_u32 s45, s45, s50
	s_add_u32 s45, s45, 524288
	s_mul_i32 s50, s28, 4352
	s_add_u32 s50, s50, 4194304
	s_add_u32 s51, s50, 64
	s_mov_b32 s22, s26
	s_mov_b32 s23, s26
	v_lshlrev_b32 v10, 4, v0
	s_mov_b32 s46, 262144
L_fw_61:
	ds_read_b32 v7, v5 offset:12
	s_waitcnt lgkmcnt(0)
	v_readfirstlane_b32 s47, v7
	s_nop 0
	s_cmp_ge_u32 s47, 1
	s_cbranch_scc1 L_fwd_62
	s_sub_u32 s46, s46, 1
	s_cbranch_scc1 L_fwd_62
	s_sleep 2
	s_branch L_fw_61
L_fwd_62:
	v_lshlrev_b32 v18, 2, v0
	s_mov_b64 exec, 0xffffffff
	s_mov_b32 s46, 16384
L_vf_63:
	buffer_load_dword v16, v18, s[40:43], s50 offen sc1
	s_waitcnt vmcnt(0)
	v_cmp_eq_u32 vcc, s26, v16
	s_nop 0
	s_cmp_eq_u64 vcc, exec
	s_cbranch_scc1 L_vfd_64
	s_sub_u32 s46, s46, 1
	s_cbranch_scc1 L_vfd_64
	s_branch L_vf_63
L_vfd_64:
	s_mov_b64 exec, -1
	s_add_u32 s51, s45, 4096
	buffer_load_dwordx4 v[64:67], v10, s[40:43], s45 offen offset:0 sc1
	buffer_load_dwordx4 v[68:71], v10, s[40:43], s45 offen offset:1024 sc1
	buffer_load_dwordx4 v[72:75], v10, s[40:43], s45 offen offset:2048 sc1
	buffer_load_dwordx4 v[76:79], v10, s[40:43], s45 offen offset:3072 sc1
	buffer_load_dwordx4 v[80:83], v10, s[40:43], s51 offen offset:0 sc1
	buffer_load_dwordx4 v[84:87], v10, s[40:43], s51 offen offset:1024 sc1
	buffer_load_dwordx4 v[88:91], v10, s[40:43], s51 offen offset:2048 sc1
	buffer_load_dwordx4 v[92:95], v10, s[40:43], s51 offen offset:3072 sc1
	s_waitcnt vmcnt(0)
	v_add_f32 v64, v64, v72
	v_add_f32 v80, v80, v88
	v_add_f32 v64, v64, v80
	v_add_f32 v65, v65, v73
	v_add_f32 v81, v81, v89
	v_add_f32 v65, v65, v81
	v_add_f32 v66, v66, v74
	v_add_f32 v82, v82, v90
	v_add_f32 v66, v66, v82
	v_add_f32 v67, v67, v75
	v_add_f32 v83, v83, v91
	v_add_f32 v67, v67, v83
	v_add_f32 v68, v68, v76
	v_add_f32 v84, v84, v92
	v_add_f32 v68, v68, v84
	v_add_f32 v69, v69, v77
	v_add_f32 v85, v85, v93
	v_add_f32 v69, v69, v85
	v_add_f32 v70, v70, v78
	v_add_f32 v86, v86, v94
	v_add_f32 v70, v70, v86
	v_add_f32 v71, v71, v79
	v_add_f32 v87, v87, v95
	v_add_f32 v71, v71, v87
	v_cvt_pk_bf16_f32 v16, v64, v65
	v_cvt_pk_bf16_f32 v17, v66, v67
	v_cvt_pk_bf16_f32 v18, v68, v69
	v_cvt_pk_bf16_f32 v19, v70, v71
	v_lshlrev_b32 v11, 3, v0
	v_add_u32 v11, 160512, v11
	ds_write_b64 v11, v[16:17]
	ds_write_b64 v11, v[18:19] offset:512
	s_mov_b64 exec, 1
	ds_add_u32 v5, v6 offset:16
	s_mov_b64 exec, -1
	s_branch L_fin
L_fin:
L_end:
	s_endpgm
.section .rodata,"a"
.p2align 6
.amdhsa_kernel parallel_sum__sliding_block_cached__dense_activation_relu__decode_kernel
  .amdhsa_next_free_vgpr 128
  .amdhsa_next_free_sgpr 100
  .amdhsa_accum_offset 128
  .amdhsa_group_segment_fixed_size 0
  .amdhsa_kernarg_size 88
  .amdhsa_user_sgpr_count 2
  .amdhsa_user_sgpr_kernarg_segment_ptr 1
  .amdhsa_system_sgpr_workgroup_id_x 1
  .amdhsa_float_denorm_mode_32 3
.end_amdhsa_kernel
```
